```python
import torch

def _softmax(x, axis=-1):
    return torch.softmax(x, dim=axis)
def _gelu(x):
    return torch.nn.functional.gelu(x, approximate="tanh")
def _silu(x):
    return torch.nn.functional.silu(x)
def _sigmoid(x):
    return torch.sigmoid(x)
def _layernorm(x, axis=-1, eps=1e-5):
    m = x.mean(dim=axis, keepdim=True)
    v = x.var(dim=axis, keepdim=True, unbiased=False)
    return (x - m) / torch.sqrt(v + eps)
def _scatter_add(tgt, idx, src, axis=0):
    return tgt.clone().index_add_(axis, idx, src)
def _segment_sum(src, seg, n):
    out = torch.zeros((n,) + src.shape[1:], dtype=src.dtype)
    return out.index_add_(0, seg, src)
def _pad(x, pw):
    flat = tuple(v for pair in reversed(pw) for v in pair)
    return torch.nn.functional.pad(x, flat)

kernel_name = 'recurrent_scan__sliding_block_cached__mixer_channel_mlp__decode'

def setup_inputs():

    _w = (lambda a: (lambda t: t.to(torch.bfloat16) if t.is_floating_point() else t)(torch.as_tensor(a)))
    def _A_setup():
        B, Sq, D = 1, 1, 512
        Hq, Hkv, Sk, Dh = 32, 8, 65536, 128
        assert Hq % Hkv == 0, (Hq, Hkv)
        return {
            "x": _w((lambda *s: torch.randn(*s, dtype=torch.bfloat16) * 0.1)(B, Sq, D)),
            "k_cache": _w((lambda *s: torch.randn(*s, dtype=torch.bfloat16) * 0.8)(B, Hkv, Sk, Dh)),
            "v_cache": _w((lambda *s: torch.randn(*s, dtype=torch.bfloat16) * 3.2)(B, Hkv, Sk, Dh)),
            "wq": _w((lambda *s: torch.randn(*s, dtype=torch.bfloat16) * 0.8)(D, Hq * Dh) * (D ** -0.5)),
            "wo": _w((lambda *s: torch.randn(*s, dtype=torch.bfloat16) * 3.2)(Hq * Dh, D) * ((Hq * Dh) ** -0.5)),
        }
    _A_in = _A_setup()

    def _B_setup():
        B, S, D, F = 1, 1, 512, 1792
        return {
            "x": _w((lambda *s: torch.randn(*s, dtype=torch.bfloat16) * 0.1)(B, S, D)),
            "w1": _w((lambda *s: torch.randn(*s, dtype=torch.bfloat16) * 3.2)(D, F) * (D ** -0.5)),
            "b1": _w((lambda *s: torch.randn(*s, dtype=torch.bfloat16) * 3.2)(F)),
            "w2": _w((lambda *s: torch.randn(*s, dtype=torch.bfloat16) * 3.2)(F, D) * (F ** -0.5)),
            "b2": _w((lambda *s: torch.randn(*s, dtype=torch.bfloat16) * 3.2)(D)),
        }
    _B_in = _B_setup()

    return {
        "A_x": _A_in["x"],
        "A_k_cache": _A_in["k_cache"],
        "A_v_cache": _A_in["v_cache"],
        "A_wq": _A_in["wq"],
        "A_wo": _A_in["wo"],
        "B_x": _B_in["x"],
        "B_w1": _B_in["w1"],
        "B_b1": _B_in["b1"],
        "B_w2": _B_in["w2"],
        "B_b2": _B_in["b2"],
    }

def reference(A_x, A_k_cache, A_v_cache, A_wq, A_wo, B_x, B_w1, B_b1, B_w2, B_b2):
    def _A_ref(x, k_cache, v_cache, wq, wo):
        B, Sq, D = x.shape
        Hq, Dh = 32, 128
        Hkv, Sk = k_cache.shape[1], k_cache.shape[2]
        W = min(4096, max(256, Sk // 4))
        rep = Hq // Hkv
        q = (lambda x, *d: x.permute(*d))((x @ wq).reshape(B, Sq, Hq, Dh), 0, 2, 1, 3)
        k = (lambda x, n, axis: torch.repeat_interleave(x, n, dim=axis))(k_cache[:, :, Sk - W:, :], rep, axis=1)
        v = (lambda x, n, axis: torch.repeat_interleave(x, n, dim=axis))(v_cache[:, :, Sk - W:, :], rep, axis=1)
        scores = torch.einsum("bhqd,bhkd->bhqk", q, k) * (Dh ** -0.5)
        p = _softmax(scores, axis=-1)
        o = torch.einsum("bhqk,bhkd->bhqd", p, v)
        return (lambda x, *d: x.permute(*d))(o, 0, 2, 1, 3).reshape(B, Sq, Hq * Dh) @ wo

    def _B_ref(x, w1, b1, w2, b2):
        y = _layernorm(x, axis=-1)
        h = _gelu(torch.einsum("bsd,df->bsf", y, w1) + b1)
        return torch.einsum("bsf,fd->bsd", h, w2) + b2

    x = A_x
    xn = _layernorm(x, axis=-1)
    s = _A_ref(xn, A_k_cache, A_v_cache, A_wq, A_wo)
    g = _silu(_B_ref(xn, B_w1, B_b1, B_w2, B_b2))
    return x + s * g
```

```asm
; @launch grid=(256,1,1) block=(384,1,1) lds=49152
.amdgcn_target "amdgcn-amd-amdhsa--gfx950"
.text
.globl recurrent_scan__sliding_block_cached__mixer_channel_mlp__decode_kernel
.p2align 8
.type recurrent_scan__sliding_block_cached__mixer_channel_mlp__decode_kernel,@function
recurrent_scan__sliding_block_cached__mixer_channel_mlp__decode_kernel:
    s_load_dwordx16 s[4:19], s[0:1], 0
    s_load_dwordx8 s[20:27], s[0:1], 64
    s_load_dwordx2 s[28:29], s[0:1], 96
    s_cmp_ge_u32 s2, 256
    s_cbranch_scc1 L_end
    v_lshrrev_b32 v1, 6, v0
    v_and_b32 v0, 63, v0
    s_getpc_b64 s[36:37]
L_pc:
    v_readfirstlane_b32 s30, v1
    s_and_b32 s31, s2, 7
    s_lshr_b32 s32, s2, 3
    s_mul_i32 s38, s32, 6
    s_add_u32 s38, s38, s30
    s_lshl_b32 s38, s38, 7
    v_mov_b32 v1, s38
    s_cmp_gt_u32 s38, L_end-L_pc
    s_cbranch_scc1 L_nopf
    s_mov_b64 exec, 1
    global_load_dword v26, v1, s[36:37]
    s_mov_b64 exec, -1
L_nopf:
    s_mul_i32 s34, s31, 311296
    s_add_u32 s34, s34, 65536
    s_mov_b32 s48, 0
    v_mov_b32 v1, 0
    v_lshlrev_b32 v2, 4, v0
    v_and_b32 v5, 15, v0
    v_lshrrev_b32 v6, 4, v0
    s_cmp_eq_u32 s30, 1
    s_cbranch_scc1 L_M
    s_cmp_gt_u32 s30, 1
    s_cbranch_scc1 L_A
    s_setprio 3
    s_mov_b32 s74, s32
    v_and_b32 v4, 1, v0
    v_lshl_add_u32 v3, v6, 1, v4
    v_lshlrev_b32 v3, 5, v3
    s_and_b32 s38, s74, 3
    s_lshl_b32 s39, s38, 8
    v_add_u32 v3, s39, v3
    v_lshrrev_b32 v4, 3, v0
    v_lshlrev_b32 v4, 17, v4
    v_and_b32 v7, 7, v0
    v_lshl_add_u32 v4, v7, 4, v4
    s_lshl_b32 s39, s38, 20
    s_lshl_b32 s38, s31, 10
    s_add_u32 s39, s39, s38
    s_lshr_b32 s38, s74, 2
    s_lshl_b32 s38, s38, 7
    s_add_u32 s39, s39, s38
    v_add_u32 v4, s39, v4
    s_mov_b32 s38, 0x3f803f80
    s_movk_i32 s39, 0x2000
    v_mov_b32 v8, s38
    v_mov_b32 v9, s38
    v_mov_b32 v10, s38
    v_mov_b32 v11, s38
    v_mov_b32 v12, s38
    v_mov_b32 v13, s38
    v_mov_b32 v14, s38
    v_mov_b32 v15, s38
    s_mov_b32 s60, 0x00030003
    s_mov_b32 s61, 0x00030003
    s_waitcnt lgkmcnt(0)
    global_load_dwordx4 v[20:23], v4, s[10:11] nt
    v_add_u32 v4, s39, v4
    global_load_dwordx4 v[24:27], v4, s[10:11] nt
    v_add_u32 v4, s39, v4
    global_load_dwordx4 v[28:31], v4, s[10:11] nt
    v_add_u32 v4, s39, v4
    global_load_dwordx4 v[32:35], v4, s[10:11] nt
    v_add_u32 v4, s39, v4
    global_load_dwordx4 v[36:39], v4, s[10:11] nt
    v_add_u32 v4, s39, v4
    global_load_dwordx4 v[40:43], v4, s[10:11] nt
    v_add_u32 v4, s39, v4
    global_load_dwordx4 v[44:47], v4, s[10:11] nt
    v_add_u32 v4, s39, v4
    global_load_dwordx4 v[48:51], v4, s[10:11] nt
    v_add_u32 v4, s39, v4
    global_load_dwordx4 v[52:55], v4, s[10:11] nt
    v_add_u32 v4, s39, v4
    global_load_dwordx4 v[56:59], v4, s[10:11] nt
    v_add_u32 v4, s39, v4
    global_load_dwordx4 v[60:63], v4, s[10:11] nt
    v_add_u32 v4, s39, v4
    global_load_dwordx4 v[64:67], v4, s[10:11] nt
    v_add_u32 v4, s39, v4
    global_load_dwordx4 v[68:71], v4, s[10:11] nt
    v_add_u32 v4, s39, v4
    global_load_dwordx4 v[72:75], v4, s[10:11] nt
    v_add_u32 v4, s39, v4
    global_load_dwordx4 v[76:79], v4, s[10:11] nt
    v_add_u32 v4, s39, v4
    global_load_dwordx4 v[80:83], v4, s[10:11] nt
    s_mov_b64 exec, s[60:61]
    global_load_dwordx4 v[8:11], v3, s[4:5]
    global_load_dwordx4 v[12:15], v3, s[4:5] offset:16
    s_mov_b64 exec, -1
    global_load_dwordx4 v[148:151], v2, s[4:5]
    s_mov_b64 exec, 1
    global_load_dword v16, v1, s[28:29] sc1
    s_mov_b64 exec, -1
    s_barrier
    s_branch L_Q2
L_M:
    s_mul_i32 s38, s32, 57344
    s_mul_i32 s39, s31, 448
    s_add_u32 s38, s38, s39
    v_lshl_add_u32 v4, v0, 3, s38
    s_movk_i32 s39, 7168
    s_mov_b32 s60, -1
    s_mov_b32 s61, 0x00ffffff
    v_lshlrev_b32 v3, 2, v0
    ds_write_b32 v3, v1 offset:1280
    s_waitcnt lgkmcnt(0)
    s_mov_b64 exec, 1
    s_barrier
    global_load_dword v16, v1, s[28:29] sc1
    s_mov_b64 exec, -1
    global_load_dwordx4 v[8:11], v2, s[4:5]
    s_branch L_M2
L_A:
    s_sub_u32 s47, s30, 2
    s_lshl_b32 s38, s31, 24
    s_lshl_b32 s39, s32, 15
    s_add_u32 s38, s38, s39
    s_lshl_b32 s39, s47, 10
    s_add_u32 s38, s38, s39
    s_add_u32 s38, s38, 15728640
    s_lshl_b32 s39, s47, 13
    s_add_u32 s39, s39, 16384
    s_mov_b32 m0, s39
    s_mov_b32 s3, s31
    v_xor_b32 v7, v5, v6
    v_lshlrev_b32 v7, 4, v7
    v_lshl_add_u32 v144, v6, 8, v7
    v_add_u32 v144, s38, v144
    v_xor_b32 v145, 64, v144
    v_xor_b32 v146, 0x80, v144
    v_xor_b32 v147, 0xc0, v144
    v_lshl_add_u32 v148, v5, 8, v7
    v_add_u32 v148, s39, v148
    v_add_u32 v4, s3, v6
    v_and_b32 v4, 7, v4
    v_lshlrev_b32 v4, 12, v4
    v_lshl_add_u32 v4, v5, 4, v4
    v_add_u32 v4, s38, v4
    v_xor_b32 v27, 0x4000, v4
    s_waitcnt lgkmcnt(0)
    s_mov_b64 exec, 1
    s_mov_b64 exec, -1
    s_add_u32 s39, s3, 0
    s_and_b32 s39, s39, 7
    s_lshl_b32 s39, s39, 12
    s_add_u32 s50, s6, s39
    s_addc_u32 s51, s7, 0
    s_add_u32 s39, s3, 1
    s_and_b32 s39, s39, 7
    s_lshl_b32 s39, s39, 12
    s_add_u32 s52, s6, s39
    s_addc_u32 s53, s7, 0
    s_add_u32 s39, s3, 2
    s_and_b32 s39, s39, 7
    s_lshl_b32 s39, s39, 12
    s_add_u32 s54, s6, s39
    s_addc_u32 s55, s7, 0
    s_add_u32 s39, s3, 3
    s_and_b32 s39, s39, 7
    s_lshl_b32 s39, s39, 12
    s_add_u32 s56, s6, s39
    s_addc_u32 s57, s7, 0
    s_add_u32 s39, s3, 4
    s_and_b32 s39, s39, 7
    s_lshl_b32 s39, s39, 12
    s_add_u32 s58, s6, s39
    s_addc_u32 s59, s7, 0
    s_add_u32 s39, s3, 5
    s_and_b32 s39, s39, 7
    s_lshl_b32 s39, s39, 12
    s_add_u32 s60, s6, s39
    s_addc_u32 s61, s7, 0
    s_add_u32 s39, s3, 6
    s_and_b32 s39, s39, 7
    s_lshl_b32 s39, s39, 12
    s_add_u32 s62, s6, s39
    s_addc_u32 s63, s7, 0
    s_add_u32 s39, s3, 7
    s_and_b32 s39, s39, 7
    s_lshl_b32 s39, s39, 12
    s_add_u32 s64, s6, s39
    s_addc_u32 s65, s7, 0
    s_barrier
    s_mov_b64 exec, 1
    global_load_dword v23, v1, s[28:29] sc1
    s_mov_b64 exec, -1
    global_load_lds_dwordx4 v144, s[50:51] nt
    s_lshl_b32 s39, s47, 11
    s_add_u32 s38, s34, s39
    s_add_u32 s38, s38, 0
    v_and_b32 v8, 1, v6
    v_lshlrev_b32 v12, 10, v8
    v_lshrrev_b32 v9, 5, v0
    v_lshl_add_u32 v12, v9, 9, v12
    v_lshl_add_u32 v12, v5, 4, v12
    v_add_u32 v12, s38, v12
    s_mul_i32 s38, s47, 320
    v_lshlrev_b32 v17, 7, v8
    v_lshl_add_u32 v17, v9, 2, v17
    v_and_b32 v7, 7, v0
    v_lshl_add_u32 v17, v7, 4, v17
    v_bfe_u32 v7, v0, 3, 1
    v_lshl_add_u32 v17, v7, 3, v17
    v_add_u32 v17, s38, v17
    s_add_u32 m0, m0, 1024
    s_nop 0
    global_load_lds_dwordx4 v145, s[52:53] nt
    s_mul_i32 s38, s47, 17408
    s_lshl_b32 s39, s32, 6
    s_add_u32 s38, s38, s39
    s_add_u32 s38, s38, s34
    s_add_u32 s39, s38, 139264
    v_lshrrev_b32 v7, 2, v5
    v_lshl_add_u32 v11, v7, 1, v8
    v_mul_u32_u24 v11, 2176, v11
    v_and_b32 v3, 3, v0
    v_lshl_add_u32 v11, v3, 4, v11
    v_add_u32 v11, s39, v11
    s_add_u32 s39, s38, 65536
    v_bfe_u32 v10, v0, 2, 3
    v_mul_u32_u24 v10, 2176, v10
    v_lshl_add_u32 v10, v3, 4, v10
    v_add_u32 v10, s39, v10
    v_mul_u32_u24 v18, 320, v7
    s_add_u32 m0, m0, 1024
    s_nop 0
    global_load_lds_dwordx4 v146, s[54:55] nt
    v_lshl_add_u32 v18, v6, 4, v18
    s_lshl_b32 s38, s47, 3
    v_lshl_add_u32 v19, v7, 5, s38
    s_mul_i32 s38, s47, 2304
    s_add_u32 s38, s38, 2048
    v_add_u32 v21, s38, v2
    s_lshl_b32 s38, s47, 8
    s_add_u32 s38, s38, 2048
    v_and_b32 v7, 1, v0
    v_mul_u32_u24 v22, 1152, v7
    v_bfe_u32 v20, v0, 1, 4
    v_lshl_add_u32 v22, v20, 4, v22
    v_add_u32 v22, s38, v22
    s_lshl_b32 s38, s31, 5
    s_add_u32 s38, s38, s32
    s_lshl_b32 s38, s38, 14
    s_lshl_b32 s39, s47, 8
    s_add_u32 m0, m0, 1024
    s_nop 0
    global_load_lds_dwordx4 v147, s[56:57] nt
    s_add_u32 s38, s38, s39
    s_add_u32 s38, s38, 4096
    v_lshlrev_b32 v14, 10, v6
    v_lshl_add_u32 v14, v5, 4, v14
    v_add_u32 v9, s38, v14
    v_add_u32 v14, 0x2000, v9
    s_lshl_b32 s39, s47, 9
    s_lshl_b32 s38, s32, 4
    s_add_u32 s39, s39, s38
    s_add_u32 s39, s39, s34
    s_add_u32 s39, s39, 16384
    v_mov_b32 v13, s39
    s_lshl_b32 s38, s47, 2
    v_mov_b32 v16, s38
    s_lshl_b32 s38, s47, 5
    v_mov_b32 v24, s38
    v_mov_b32 v25, 1
    s_add_u32 m0, m0, 1024
    s_nop 0
    global_load_lds_dwordx4 v144, s[58:59] nt
    s_mov_b32 s40, 0x05040100
    s_mov_b32 s41, 0x07060302
    s_mov_b32 s42, 0x07060501
    s_mov_b32 s43, 0x07060502
    s_mov_b32 s44, 0x07060503
    s_mov_b32 s45, 0x0c04000c
    s_mov_b32 s46, 0x04020100
    s_getreg_b32 s33, hwreg(HW_REG_XCC_ID)
    s_and_b32 s33, s33, 7
    v_cmp_eq_u32 vcc, 1, v7
    v_mov_b32 v136, 0x0000ffff
    v_mov_b32 v137, 0xffff0000
    v_cndmask_b32 v136, v136, v137, vcc
    v_bfe_u32 v138, v0, 1, 3
    v_cmp_eq_u32 vcc, 0, v138
    s_nop 1
    v_cndmask_b32 v28, 0, v136, vcc
    v_cmp_eq_u32 vcc, 1, v138
    s_add_u32 m0, m0, 1024
    s_nop 0
    global_load_lds_dwordx4 v145, s[60:61] nt
    v_cndmask_b32 v29, 0, v136, vcc
    v_cmp_eq_u32 vcc, 2, v138
    s_nop 1
    v_cndmask_b32 v30, 0, v136, vcc
    v_cmp_eq_u32 vcc, 3, v138
    s_nop 1
    v_cndmask_b32 v31, 0, v136, vcc
    s_mov_b32 s66, 0x11111111
    s_mov_b32 s67, 0x11111111
    s_mov_b32 s68, 0x22222222
    s_mov_b32 s69, 0x22222222
    s_mov_b32 s70, 0x44444444
    s_mov_b32 s71, 0x44444444
    s_mov_b32 s72, 0x88888888
    s_mov_b32 s73, 0x88888888
    v_xor_b32 v149, 64, v148
    v_xor_b32 v150, 0x80, v148
    v_xor_b32 v151, 0xc0, v148
    v_mov_b32 v163, 0
    v_mov_b32 v167, 0
    s_waitcnt vmcnt(5)
    v_readfirstlane_b32 s35, v23
    s_add_u32 s35, s35, 0x9E3779B9
    s_or_b32 s35, s35, 1
    s_add_u32 m0, m0, 1024
    s_nop 0
    global_load_lds_dwordx4 v146, s[62:63] nt
    s_waitcnt vmcnt(5)
    s_add_u32 m0, m0, 1024
    s_nop 0
    global_load_lds_dwordx4 v147, s[64:65] nt
    s_waitcnt vmcnt(5)
    global_load_dwordx4 v[64:67], v4, s[8:9] offset:0 nt
    s_waitcnt vmcnt(5)
    global_load_dwordx4 v[68:71], v4, s[8:9] offset:256 nt
    global_load_dwordx4 v[160:163], v12, s[28:29] sc1
    global_load_dwordx4 v[164:167], v12, s[28:29] offset:256 sc1
    s_waitcnt vmcnt(7)
    global_load_dwordx4 v[72:75], v4, s[8:9] offset:512 nt
    s_waitcnt vmcnt(7)
    global_load_dwordx4 v[76:79], v4, s[8:9] offset:768 nt
    s_waitcnt vmcnt(7)
    global_load_dwordx4 v[80:83], v27, s[8:9] offset:0 nt
    global_load_dwordx4 v[160:163], v12, s[28:29] sc1
    global_load_dwordx4 v[164:167], v12, s[28:29] offset:256 sc1
    s_waitcnt vmcnt(9)
    global_load_dwordx4 v[84:87], v27, s[8:9] offset:256 nt
    ds_read_b128 v[32:35], v148 offset:0
    ds_read_b128 v[36:39], v149 offset:0
    ds_read_b128 v[40:43], v150 offset:0
    ds_read_b128 v[44:47], v151 offset:0
    ds_read_b128 v[48:51], v148 offset:4096
    ds_read_b128 v[52:55], v149 offset:4096
    ds_read_b128 v[56:59], v150 offset:4096
    ds_read_b128 v[60:63], v151 offset:4096
    s_waitcnt vmcnt(9)
    global_load_dwordx4 v[88:91], v27, s[8:9] offset:512 nt
    s_waitcnt vmcnt(9)
    global_load_dwordx4 v[92:95], v27, s[8:9] offset:768 nt
    global_load_dwordx4 v[160:163], v12, s[28:29] sc1
    global_load_dwordx4 v[164:167], v12, s[28:29] offset:256 sc1
    ds_write_b32 v16, v25 offset:1312
    s_branch L_A2
L_Q2:
    s_mov_b32 s40, 0x05040100
    s_mov_b32 s41, 0x07060302
    s_mov_b32 s42, 0x07060501
    s_mov_b32 s43, 0x07060502
    s_mov_b32 s44, 0x07060503
    s_mov_b32 s45, 0x0c04000c
    s_mov_b32 s46, 0x04020100
    s_getreg_b32 s33, hwreg(HW_REG_XCC_ID)
    s_and_b32 s33, s33, 7
    s_lshl_b32 s3, s33, 8
    v_mov_b32 v17, s3
    s_movk_i32 s62, 0x700
    s_lshl_b32 s39, s74, 8
    s_add_u32 s39, s39, s34
    v_add_u32 v18, s39, v2
    v_add_u32 v3, 8192, v18
    v_mov_b32 v19, 0
    s_waitcnt vmcnt(18)
    v_perm_b32 v84, v24, v20, s40
    v_perm_b32 v88, v24, v20, s41
    v_perm_b32 v92, v25, v21, s40
    v_perm_b32 v96, v25, v21, s41
    v_perm_b32 v100, v26, v22, s40
    v_perm_b32 v104, v26, v22, s41
    v_perm_b32 v108, v27, v23, s40
    v_perm_b32 v112, v27, v23, s41
    s_waitcnt vmcnt(16)
    v_perm_b32 v85, v32, v28, s40
    v_perm_b32 v89, v32, v28, s41
    v_perm_b32 v93, v33, v29, s40
    v_perm_b32 v97, v33, v29, s41
    v_perm_b32 v101, v34, v30, s40
    v_perm_b32 v105, v34, v30, s41
    v_perm_b32 v109, v35, v31, s40
    v_perm_b32 v113, v35, v31, s41
    s_waitcnt vmcnt(14)
    v_perm_b32 v86, v40, v36, s40
    v_perm_b32 v90, v40, v36, s41
    v_perm_b32 v94, v41, v37, s40
    v_perm_b32 v98, v41, v37, s41
    v_perm_b32 v102, v42, v38, s40
    v_perm_b32 v106, v42, v38, s41
    v_perm_b32 v110, v43, v39, s40
    v_perm_b32 v114, v43, v39, s41
    s_waitcnt vmcnt(12)
    v_perm_b32 v87, v48, v44, s40
    v_perm_b32 v91, v48, v44, s41
    v_perm_b32 v95, v49, v45, s40
    v_perm_b32 v99, v49, v45, s41
    v_perm_b32 v103, v50, v46, s40
    v_perm_b32 v107, v50, v46, s41
    v_perm_b32 v111, v51, v47, s40
    v_perm_b32 v115, v51, v47, s41
    s_waitcnt vmcnt(10)
    v_perm_b32 v20, v56, v52, s40
    v_perm_b32 v24, v56, v52, s41
    v_perm_b32 v28, v57, v53, s40
    v_perm_b32 v32, v57, v53, s41
    v_perm_b32 v36, v58, v54, s40
    v_perm_b32 v40, v58, v54, s41
    v_perm_b32 v44, v59, v55, s40
    v_perm_b32 v48, v59, v55, s41
    s_waitcnt vmcnt(8)
    v_perm_b32 v21, v64, v60, s40
    v_perm_b32 v25, v64, v60, s41
    v_perm_b32 v29, v65, v61, s40
    v_perm_b32 v33, v65, v61, s41
    v_perm_b32 v37, v66, v62, s40
    v_perm_b32 v41, v66, v62, s41
    v_perm_b32 v45, v67, v63, s40
    v_perm_b32 v49, v67, v63, s41
    s_waitcnt vmcnt(6)
    v_perm_b32 v22, v72, v68, s40
    v_perm_b32 v26, v72, v68, s41
    v_perm_b32 v30, v73, v69, s40
    v_perm_b32 v34, v73, v69, s41
    v_perm_b32 v38, v74, v70, s40
    v_perm_b32 v42, v74, v70, s41
    v_perm_b32 v46, v75, v71, s40
    v_perm_b32 v50, v75, v71, s41
    s_waitcnt vmcnt(4)
    v_perm_b32 v23, v80, v76, s40
    v_perm_b32 v27, v80, v76, s41
    v_perm_b32 v31, v81, v77, s40
    v_perm_b32 v35, v81, v77, s41
    v_perm_b32 v39, v82, v78, s40
    v_perm_b32 v43, v82, v78, s41
    v_perm_b32 v47, v83, v79, s40
    v_perm_b32 v51, v83, v79, s41
    s_waitcnt vmcnt(2)
    v_mfma_f32_16x16x32_bf16 v[116:119], v[8:11], v[84:87], 0
    v_mfma_f32_16x16x32_bf16 v[120:123], v[8:11], v[88:91], 0
    v_mfma_f32_16x16x32_bf16 v[124:127], v[8:11], v[92:95], 0
    v_mfma_f32_16x16x32_bf16 v[128:131], v[8:11], v[96:99], 0
    v_mfma_f32_16x16x32_bf16 v[132:135], v[8:11], v[100:103], 0
    v_mfma_f32_16x16x32_bf16 v[136:139], v[8:11], v[104:107], 0
    v_mfma_f32_16x16x32_bf16 v[140:143], v[8:11], v[108:111], 0
    v_mfma_f32_16x16x32_bf16 v[144:147], v[8:11], v[112:115], 0
    v_mfma_f32_16x16x32_bf16 v[116:119], v[12:15], v[20:23], v[116:119]
    v_mfma_f32_16x16x32_bf16 v[120:123], v[12:15], v[24:27], v[120:123]
    v_mfma_f32_16x16x32_bf16 v[124:127], v[12:15], v[28:31], v[124:127]
    v_mfma_f32_16x16x32_bf16 v[128:131], v[12:15], v[32:35], v[128:131]
    v_mfma_f32_16x16x32_bf16 v[132:135], v[12:15], v[36:39], v[132:135]
    v_mfma_f32_16x16x32_bf16 v[136:139], v[12:15], v[40:43], v[136:139]
    v_mfma_f32_16x16x32_bf16 v[140:143], v[12:15], v[44:47], v[140:143]
    v_mfma_f32_16x16x32_bf16 v[144:147], v[12:15], v[48:51], v[144:147]
    s_waitcnt vmcnt(0)
    v_dot2c_f32_bf16 v19, s38, v148
    v_dot2c_f32_bf16 v19, s38, v149
    v_dot2c_f32_bf16 v19, s38, v150
    v_dot2c_f32_bf16 v19, s38, v151
    v_readfirstlane_b32 s35, v16
    s_add_u32 s35, s35, 0x9E3779B9
    s_or_b32 s35, s35, 1
    v_add_f32_dpp v19, v19, v19 row_shr:1 row_mask:0xf bank_mask:0xf bound_ctrl:0
    s_nop 1
    v_add_f32_dpp v19, v19, v19 row_shr:2 row_mask:0xf bank_mask:0xf bound_ctrl:0
    s_nop 1
    v_add_f32_dpp v19, v19, v19 row_shr:4 row_mask:0xf bank_mask:0xf bound_ctrl:0
    s_nop 1
    v_add_f32_dpp v19, v19, v19 row_shr:8 row_mask:0xf bank_mask:0xf bound_ctrl:0
    s_nop 1
    v_add_f32_dpp v19, v19, v19 row_bcast:15 row_mask:0xa bank_mask:0xf
    s_nop 1
    v_add_f32_dpp v19, v19, v19 row_bcast:31 row_mask:0xc bank_mask:0xf
    s_nop 0
    v_readlane_b32 s63, v19, 63
    v_mov_b32 v19, 0x3b000000
    s_nop 0
    v_mul_f32 v19, s63, v19
    v_cvt_pk_bf16_f32 v19, v19, v19
    v_and_b32 v19, 0xffff0000, v19
    v_mov_b32 v23, s35
    v_mov_b32 v27, s35
    v_add_f32_dpp v116, v117, v116 row_ror:8 row_mask:0xf bank_mask:0xf
    v_add_f32_dpp v118, v118, v118 row_ror:8 row_mask:0xf bank_mask:0xf
    v_fma_f32 v116, -v19, v118, v116
    v_add_f32_dpp v120, v121, v120 row_ror:8 row_mask:0xf bank_mask:0xf
    v_add_f32_dpp v122, v122, v122 row_ror:8 row_mask:0xf bank_mask:0xf
    v_fma_f32 v120, -v19, v122, v120
    v_add_f32_dpp v124, v125, v124 row_ror:8 row_mask:0xf bank_mask:0xf
    v_add_f32_dpp v126, v126, v126 row_ror:8 row_mask:0xf bank_mask:0xf
    v_fma_f32 v124, -v19, v126, v124
    v_add_f32_dpp v128, v129, v128 row_ror:8 row_mask:0xf bank_mask:0xf
    v_add_f32_dpp v130, v130, v130 row_ror:8 row_mask:0xf bank_mask:0xf
    v_fma_f32 v128, -v19, v130, v128
    v_add_f32_dpp v132, v133, v132 row_ror:8 row_mask:0xf bank_mask:0xf
    v_add_f32_dpp v134, v134, v134 row_ror:8 row_mask:0xf bank_mask:0xf
    v_fma_f32 v132, -v19, v134, v132
    v_add_f32_dpp v136, v137, v136 row_ror:8 row_mask:0xf bank_mask:0xf
    v_add_f32_dpp v138, v138, v138 row_ror:8 row_mask:0xf bank_mask:0xf
    v_fma_f32 v136, -v19, v138, v136
    v_add_f32_dpp v140, v141, v140 row_ror:8 row_mask:0xf bank_mask:0xf
    v_add_f32_dpp v142, v142, v142 row_ror:8 row_mask:0xf bank_mask:0xf
    v_fma_f32 v140, -v19, v142, v140
    v_add_f32_dpp v144, v145, v144 row_ror:8 row_mask:0xf bank_mask:0xf
    v_add_f32_dpp v146, v146, v146 row_ror:8 row_mask:0xf bank_mask:0xf
    v_fma_f32 v144, -v19, v146, v144
    v_perm_b32 v20, v116, v128, s42
    v_perm_b32 v21, v120, v128, s43
    v_perm_b32 v22, v124, v128, s44
    v_bfi_b32 v20, s62, v17, v20
    v_perm_b32 v24, v132, v144, s42
    v_perm_b32 v25, v136, v144, s43
    v_perm_b32 v26, v140, v144, s44
    v_bfi_b32 v24, s62, v17, v24
    s_mov_b64 exec, 0xff
    global_store_dwordx4 v18, v[20:23], s[28:29]
    global_store_dwordx4 v18, v[24:27], s[28:29] offset:128
    global_store_dwordx4 v3, v[20:23], s[28:29] sc1
    global_store_dwordx4 v3, v[24:27], s[28:29] offset:128 sc1
    s_mov_b64 exec, -1
    s_mul_i32 s38, s32, 2176
    s_add_u32 s38, s38, s34
    s_add_u32 s39, s38, 65536
    v_add_u32 v8, s39, v2
    s_add_u32 s39, s38, 139264
    v_add_u32 v9, s39, v2
    s_lshr_b32 s39, s32, 3
    s_lshl_b32 s39, s39, 9
    s_add_u32 s39, s39, s34
    s_add_u32 s39, s39, 16384
    v_lshrrev_b32 v10, 2, v0
    v_lshl_add_u32 v10, v10, 4, s39
    s_lshl_b32 s38, s32, 10
    s_lshl_b32 s39, s31, 7
    s_add_u32 s38, s38, s39
    s_add_u32 s38, s38, 2621440
    v_and_b32 v11, 3, v0
    v_lshl_add_u32 v11, v6, 2, v11
    v_lshlrev_b32 v14, 2, v11
    v_lshl_add_u32 v11, v11, 3, s38
    v_mov_b32 v13, s35
    v_mov_b32 v15, 1
    v_mov_b32 v35, 0
    v_mov_b32 v39, 0
    v_mov_b32 v43, 0
    v_mov_b32 v47, 0
    v_mov_b32 v51, 0
    v_mov_b32 v55, 0
    s_mov_b32 s60, 0x000f000f
    s_mov_b32 s61, 0x000f000f
L_Q_vi:
    s_sleep 1
    ds_read_b128 v[28:31], v1 offset:1312
    s_add_u32 s48, s48, 1
    s_cmp_gt_u32 s48, 400000
    s_cbranch_scc1 L_end
    s_waitcnt lgkmcnt(0)
    v_and_b32 v28, v28, v29
    v_and_b32 v30, v30, v31
    v_and_b32 v28, v28, v30
    v_cmp_eq_u32 vcc, 0, v28
    s_cbranch_vccnz L_Q_vi
    global_load_dwordx4 v[48:51], v10, s[28:29] offset:0 sc1
    global_load_dwordx4 v[52:55], v10, s[28:29] offset:256 sc1
    global_load_dwordx4 v[32:35], v8, s[28:29] offset:0 sc1
    global_load_dwordx4 v[36:39], v8, s[28:29] offset:1024 sc1
    global_load_dwordx4 v[40:43], v9, s[28:29] offset:0 sc1
    global_load_dwordx4 v[44:47], v9, s[28:29] offset:1024 sc1
L_Q_fz:
    ds_read_b32 v28, v1 offset:1480
    s_add_u32 s48, s48, 1
    s_cmp_gt_u32 s48, 400000
    s_cbranch_scc1 L_end
    s_waitcnt lgkmcnt(0)
    v_cmp_eq_u32 vcc, 0, v28
    s_cbranch_vccnz L_Q_fz
    s_mov_b64 s[50:51], -1
L_ML_l:
    s_wqm_b64 exec, s[50:51]
    global_load_dwordx4 v[48:51], v10, s[28:29] offset:0 sc1
    global_load_dwordx4 v[52:55], v10, s[28:29] offset:256 sc1
    global_load_dwordx4 v[32:35], v8, s[28:29] offset:0 sc1
    global_load_dwordx4 v[36:39], v8, s[28:29] offset:1024 sc1
    s_mov_b64 exec, -1
    s_add_u32 s48, s48, 1
    s_cmp_gt_u32 s48, 400000
    s_cbranch_scc1 L_end
    s_waitcnt vmcnt(56)
    s_sleep 1
    v_cmp_ne_u32 s[50:51], s35, v51
    v_cmp_ne_u32 s[52:53], s35, v55
    s_or_b64 s[50:51], s[50:51], s[52:53]
    s_cbranch_scc0 L_ML_x
    s_sleep 1
L_ML_c:
    v_cmp_ne_u32 s[54:55], s35, v35
    v_cmp_ne_u32 s[56:57], s35, v39
    v_cmp_ne_u32 s[50:51], s35, v51
    v_cmp_ne_u32 s[52:53], s35, v55
    s_or_b64 s[50:51], s[50:51], s[52:53]
    s_cbranch_scc0 L_ML_x
    s_or_b64 s[50:51], s[50:51], s[54:55]
    s_or_b64 s[50:51], s[50:51], s[56:57]
    s_branch L_ML_l
L_ML_x:
    global_load_dwordx4 v[32:35], v8, s[28:29] offset:0 sc1
    global_load_dwordx4 v[36:39], v8, s[28:29] offset:1024 sc1
    v_max_f32 v56, v48, v52
    s_nop 1
    v_max_f32_dpp v56, v56, v56 row_ror:8 row_mask:0xf bank_mask:0xf
    s_nop 1
    v_max_f32_dpp v56, v56, v56 row_ror:4 row_mask:0xf bank_mask:0xf
    v_mov_b32 v57, v56
    s_nop 1
    v_permlane32_swap_b32 v56, v57
    v_max_f32 v56, v56, v57
    v_mov_b32 v57, v56
    s_nop 1
    v_permlane16_swap_b32 v56, v57
    v_max_f32 v56, v56, v57
    v_sub_f32 v58, v48, v56
    v_sub_f32 v59, v52, v56
    v_cmp_ne_u32 s[50:51], s35, v35
    v_exp_f32 v58, v58
    v_cmp_ne_u32 s[52:53], s35, v39
    v_exp_f32 v59, v59
    s_or_b64 s[50:51], s[50:51], s[52:53]
    s_cbranch_scc0 L_O_ok
L_O_l:
    s_wqm_b64 exec, s[50:51]
    global_load_dwordx4 v[32:35], v8, s[28:29] offset:0 sc1
    global_load_dwordx4 v[36:39], v8, s[28:29] offset:1024 sc1
    s_mov_b64 exec, -1
    s_add_u32 s48, s48, 1
    s_cmp_gt_u32 s48, 400000
    s_cbranch_scc1 L_end
    s_waitcnt vmcnt(56)
    s_sleep 1
L_O_c:
    v_cmp_ne_u32 s[50:51], s35, v35
    v_cmp_ne_u32 s[52:53], s35, v39
    s_or_b64 s[50:51], s[50:51], s[52:53]
    s_cbranch_scc1 L_O_l
L_O_x:
L_O_ok:
    v_mul_f32 v56, v58, v49
    v_perm_b32 v63, v33, v32, s45
    v_fmac_f32 v56, v59, v53
    v_perm_b32 v64, v37, v36, s45
    v_perm_b32 v63, v34, v63, s46
    v_add_f32_dpp v56, v56, v56 row_ror:8 row_mask:0xf bank_mask:0xf
    v_perm_b32 v64, v38, v64, s46
    v_mul_f32 v60, v32, v58
    v_add_f32_dpp v56, v56, v56 row_ror:4 row_mask:0xf bank_mask:0xf
    v_mul_f32 v62, v34, v58
    v_mov_b32 v57, v56
    v_mul_f32 v61, v33, v58
    v_mul_f32 v63, v63, v58
    v_permlane32_swap_b32 v56, v57
    v_fmac_f32 v60, v36, v59
    v_fmac_f32 v62, v38, v59
    v_add_f32 v56, v56, v57
    v_fmac_f32 v61, v37, v59
    v_fmac_f32 v63, v64, v59
    v_mov_b32 v57, v56
    v_permlane32_swap_b32 v60, v62
    v_permlane32_swap_b32 v61, v63
    v_permlane16_swap_b32 v56, v57
    v_add_f32 v60, v60, v62
    v_add_f32 v61, v61, v63
    v_add_f32 v56, v56, v57
    v_rcp_f32 v56, v56
    v_permlane16_swap_b32 v60, v61
    v_add_f32 v60, v60, v61
    s_nop 1
    v_add_f32_dpp v60, v60, v60 row_ror:8 row_mask:0xf bank_mask:0xf
    s_nop 1
    v_add_f32_dpp v60, v60, v60 row_ror:4 row_mask:0xf bank_mask:0xf
    v_mul_f32 v60, v60, v56
    v_cvt_pk_bf16_f32 v60, v60, v60
    ds_write_b32 v14, v60 offset:1536
    ds_write_b32 v1, v15 offset:1472
    s_mov_b64 s[50:51], -1
L_S_l:
    s_wqm_b64 exec, s[50:51]
    global_load_dwordx4 v[40:43], v9, s[28:29] offset:0 sc1
    global_load_dwordx4 v[44:47], v9, s[28:29] offset:1024 sc1
    s_mov_b64 exec, -1
    s_add_u32 s48, s48, 1
    s_cmp_gt_u32 s48, 400000
    s_cbranch_scc1 L_end
    s_waitcnt vmcnt(56)
    s_sleep 1
L_S_c:
    v_cmp_ne_u32 s[50:51], s35, v43
    v_cmp_ne_u32 s[52:53], s35, v47
    s_or_b64 s[50:51], s[50:51], s[52:53]
    s_cbranch_scc1 L_S_l
L_S_x:
    v_perm_b32 v63, v41, v40, s45
    v_perm_b32 v63, v42, v63, s46
    v_perm_b32 v64, v45, v44, s45
    v_perm_b32 v64, v46, v64, s46
    v_add_f32 v60, v40, v44
    v_add_f32 v61, v41, v45
    v_add_f32 v62, v42, v46
    v_add_f32 v63, v63, v64
    s_nop 0
    v_permlane32_swap_b32 v60, v62
    v_permlane32_swap_b32 v61, v63
    v_add_f32 v60, v60, v62
    v_add_f32 v61, v61, v63
    s_nop 1
    v_permlane16_swap_b32 v60, v61
    v_add_f32 v60, v60, v61
    s_nop 1
    v_add_f32_dpp v60, v60, v60 row_ror:8 row_mask:0xf bank_mask:0xf
    s_nop 1
    v_add_f32_dpp v12, v60, v60 row_ror:4 row_mask:0xf bank_mask:0xf
    s_mov_b64 exec, s[60:61]
    global_store_dwordx2 v11, v[12:13], s[28:29] sc1
    ds_write_b32 v1, v15 offset:1476
    s_waitcnt lgkmcnt(0)
    s_branch L_fin
L_M2:
    s_mov_b32 s40, 0x05040100
    s_mov_b32 s41, 0x07060302
    s_mov_b32 s42, 0x07060501
    s_mov_b32 s43, 0x07060502
    s_mov_b32 s44, 0x07060503
    s_mov_b32 s45, 0x0c04000c
    s_mov_b32 s46, 0x04020100
    s_getreg_b32 s33, hwreg(HW_REG_XCC_ID)
    s_and_b32 s33, s33, 7
    s_mul_i32 s39, s32, 896
    s_add_u32 s39, s39, s34
    s_add_u32 s39, s39, 20480
    v_add_u32 v18, s39, v2
    s_lshl_b32 s62, s32, 1
    s_add_u32 s63, s62, 1
    s_lshl_b32 s3, s33, 8
    v_mov_b32 v17, s3
    s_waitcnt vmcnt(0)
    v_readfirstlane_b32 s35, v16
    s_add_u32 s35, s35, 0x9E3779B9
    s_or_b32 s35, s35, 1
    v_lshlrev_b32 v60, 16, v8
    v_and_b32 v61, 0xffff0000, v8
    v_lshlrev_b32 v62, 16, v9
    v_and_b32 v63, 0xffff0000, v9
    v_lshlrev_b32 v64, 16, v10
    v_and_b32 v65, 0xffff0000, v10
    v_lshlrev_b32 v66, 16, v11
    v_and_b32 v67, 0xffff0000, v11
    v_readfirstlane_b32 s38, v60
    s_nop 1
    v_subrev_f32 v70, s38, v60
    v_subrev_f32 v71, s38, v61
    v_subrev_f32 v72, s38, v62
    v_subrev_f32 v73, s38, v63
    v_subrev_f32 v74, s38, v64
    v_subrev_f32 v75, s38, v65
    v_subrev_f32 v76, s38, v66
    v_subrev_f32 v77, s38, v67
    v_add_f32 v68, v70, v71
    v_mul_f32 v69, v70, v70
    v_fmac_f32 v69, v71, v71
    v_add_f32 v68, v68, v72
    v_fmac_f32 v69, v72, v72
    v_add_f32 v68, v68, v73
    v_fmac_f32 v69, v73, v73
    v_add_f32 v68, v68, v74
    v_fmac_f32 v69, v74, v74
    v_add_f32 v68, v68, v75
    v_fmac_f32 v69, v75, v75
    v_add_f32 v68, v68, v76
    v_fmac_f32 v69, v76, v76
    v_add_f32 v68, v68, v77
    v_fmac_f32 v69, v77, v77
    s_nop 0
    v_add_f32_dpp v68, v68, v68 row_shr:1 row_mask:0xf bank_mask:0xf bound_ctrl:0
    v_add_f32_dpp v69, v69, v69 row_shr:1 row_mask:0xf bank_mask:0xf bound_ctrl:0
    s_nop 0
    v_add_f32_dpp v68, v68, v68 row_shr:2 row_mask:0xf bank_mask:0xf bound_ctrl:0
    v_add_f32_dpp v69, v69, v69 row_shr:2 row_mask:0xf bank_mask:0xf bound_ctrl:0
    s_nop 0
    v_add_f32_dpp v68, v68, v68 row_shr:4 row_mask:0xf bank_mask:0xf bound_ctrl:0
    v_add_f32_dpp v69, v69, v69 row_shr:4 row_mask:0xf bank_mask:0xf bound_ctrl:0
    s_nop 0
    v_add_f32_dpp v68, v68, v68 row_shr:8 row_mask:0xf bank_mask:0xf bound_ctrl:0
    v_add_f32_dpp v69, v69, v69 row_shr:8 row_mask:0xf bank_mask:0xf bound_ctrl:0
    s_nop 0
    v_add_f32_dpp v68, v68, v68 row_bcast:15 row_mask:0xa bank_mask:0xf
    v_add_f32_dpp v69, v69, v69 row_bcast:15 row_mask:0xa bank_mask:0xf
    s_nop 0
    v_add_f32_dpp v68, v68, v68 row_bcast:31 row_mask:0xc bank_mask:0xf
    v_add_f32_dpp v69, v69, v69 row_bcast:31 row_mask:0xc bank_mask:0xf
    v_readlane_b32 s39, v68, 63
    v_readlane_b32 s64, v69, 63
    v_mov_b32 v70, 0x3b000000
    v_mul_f32 v68, s39, v70
    v_mul_f32 v69, s64, v70
    v_fma_f32 v69, -v68, v68, v69
    v_max_f32 v69, 0, v69
    v_add_f32 v68, s38, v68
    v_cvt_pk_bf16_f32 v68, v68, v68
    v_and_b32 v68, 0xffff0000, v68
    v_cvt_pk_bf16_f32 v69, v69, v69
    v_and_b32 v69, 0xffff0000, v69
    v_add_f32 v69, 0x3727c5ac, v69
    v_cvt_pk_bf16_f32 v69, v69, v69
    v_and_b32 v69, 0xffff0000, v69
    v_sqrt_f32 v69, v69
    s_nop 0
    v_cvt_pk_bf16_f32 v69, v69, v69
    v_and_b32 v69, 0xffff0000, v69
    v_rcp_f32 v69, v69
    s_nop 0
    v_mul_f32 v70, 0x3e0293ee, v69
    v_or_b32 v70, 1, v70
    ds_write_b32 v1, v70 offset:1296
    v_sub_f32 v60, v60, v68
    v_sub_f32 v61, v61, v68
    v_sub_f32 v62, v62, v68
    v_sub_f32 v63, v63, v68
    v_sub_f32 v64, v64, v68
    v_sub_f32 v65, v65, v68
    v_sub_f32 v66, v66, v68
    v_sub_f32 v67, v67, v68
    v_cvt_pk_bf16_f32 v8, v60, v61
    v_cvt_pk_bf16_f32 v9, v62, v63
    v_cvt_pk_bf16_f32 v10, v64, v65
    v_cvt_pk_bf16_f32 v11, v66, v67
    v_lshlrev_b32 v60, 16, v8
    v_and_b32 v61, 0xffff0000, v8
    v_lshlrev_b32 v62, 16, v9
    v_and_b32 v63, 0xffff0000, v9
    v_lshlrev_b32 v64, 16, v10
    v_and_b32 v65, 0xffff0000, v10
    v_lshlrev_b32 v66, 16, v11
    v_and_b32 v67, 0xffff0000, v11
    v_mul_f32 v60, v60, v69
    v_mul_f32 v61, v61, v69
    v_mul_f32 v62, v62, v69
    v_mul_f32 v63, v63, v69
    v_mul_f32 v64, v64, v69
    v_mul_f32 v65, v65, v69
    v_mul_f32 v66, v66, v69
    v_mul_f32 v67, v67, v69
    v_cvt_pk_bf16_f32 v8, v60, v61
    v_cvt_pk_bf16_f32 v9, v62, v63
    v_cvt_pk_bf16_f32 v10, v64, v65
    v_cvt_pk_bf16_f32 v11, v66, v67
    v_lshlrev_b32 v60, 16, v8
    v_and_b32 v61, 0xffff0000, v8
    v_lshlrev_b32 v62, 16, v9
    v_and_b32 v63, 0xffff0000, v9
    v_lshlrev_b32 v64, 16, v10
    v_and_b32 v65, 0xffff0000, v10
    v_lshlrev_b32 v66, 16, v11
    v_and_b32 v67, 0xffff0000, v11
    v_readfirstlane_b32 s38, v60
    s_nop 1
    v_subrev_f32 v70, s38, v60
    v_subrev_f32 v71, s38, v61
    v_subrev_f32 v72, s38, v62
    v_subrev_f32 v73, s38, v63
    v_subrev_f32 v74, s38, v64
    v_subrev_f32 v75, s38, v65
    v_subrev_f32 v76, s38, v66
    v_subrev_f32 v77, s38, v67
    v_add_f32 v68, v70, v71
    v_mul_f32 v69, v70, v70
    v_fmac_f32 v69, v71, v71
    v_add_f32 v68, v68, v72
    v_fmac_f32 v69, v72, v72
    v_add_f32 v68, v68, v73
    v_fmac_f32 v69, v73, v73
    v_add_f32 v68, v68, v74
    v_fmac_f32 v69, v74, v74
    v_add_f32 v68, v68, v75
    v_fmac_f32 v69, v75, v75
    v_add_f32 v68, v68, v76
    v_fmac_f32 v69, v76, v76
    v_add_f32 v68, v68, v77
    v_fmac_f32 v69, v77, v77
    s_nop 0
    v_add_f32_dpp v68, v68, v68 row_shr:1 row_mask:0xf bank_mask:0xf bound_ctrl:0
    v_add_f32_dpp v69, v69, v69 row_shr:1 row_mask:0xf bank_mask:0xf bound_ctrl:0
    s_nop 0
    v_add_f32_dpp v68, v68, v68 row_shr:2 row_mask:0xf bank_mask:0xf bound_ctrl:0
    v_add_f32_dpp v69, v69, v69 row_shr:2 row_mask:0xf bank_mask:0xf bound_ctrl:0
    s_nop 0
    v_add_f32_dpp v68, v68, v68 row_shr:4 row_mask:0xf bank_mask:0xf bound_ctrl:0
    v_add_f32_dpp v69, v69, v69 row_shr:4 row_mask:0xf bank_mask:0xf bound_ctrl:0
    s_nop 0
    v_add_f32_dpp v68, v68, v68 row_shr:8 row_mask:0xf bank_mask:0xf bound_ctrl:0
    v_add_f32_dpp v69, v69, v69 row_shr:8 row_mask:0xf bank_mask:0xf bound_ctrl:0
    s_nop 0
    v_add_f32_dpp v68, v68, v68 row_bcast:15 row_mask:0xa bank_mask:0xf
    v_add_f32_dpp v69, v69, v69 row_bcast:15 row_mask:0xa bank_mask:0xf
    s_nop 0
    v_add_f32_dpp v68, v68, v68 row_bcast:31 row_mask:0xc bank_mask:0xf
    v_add_f32_dpp v69, v69, v69 row_bcast:31 row_mask:0xc bank_mask:0xf
    v_readlane_b32 s39, v68, 63
    v_readlane_b32 s64, v69, 63
    v_mov_b32 v70, 0x3b000000
    v_mul_f32 v68, s39, v70
    v_mul_f32 v69, s64, v70
    v_fma_f32 v69, -v68, v68, v69
    v_max_f32 v69, 0, v69
    v_add_f32 v68, s38, v68
    v_cvt_pk_bf16_f32 v68, v68, v68
    v_and_b32 v68, 0xffff0000, v68
    v_cvt_pk_bf16_f32 v69, v69, v69
    v_and_b32 v69, 0xffff0000, v69
    v_add_f32 v69, 0x3727c5ac, v69
    v_cvt_pk_bf16_f32 v69, v69, v69
    v_and_b32 v69, 0xffff0000, v69
    v_sqrt_f32 v69, v69
    s_nop 0
    v_cvt_pk_bf16_f32 v69, v69, v69
    v_and_b32 v69, 0xffff0000, v69
    v_rcp_f32 v69, v69
    v_sub_f32 v60, v60, v68
    v_sub_f32 v61, v61, v68
    v_sub_f32 v62, v62, v68
    v_sub_f32 v63, v63, v68
    v_sub_f32 v64, v64, v68
    v_sub_f32 v65, v65, v68
    v_sub_f32 v66, v66, v68
    v_sub_f32 v67, v67, v68
    v_cvt_pk_bf16_f32 v8, v60, v61
    v_cvt_pk_bf16_f32 v9, v62, v63
    v_cvt_pk_bf16_f32 v10, v64, v65
    v_cvt_pk_bf16_f32 v11, v66, v67
    v_lshlrev_b32 v60, 16, v8
    v_and_b32 v61, 0xffff0000, v8
    v_lshlrev_b32 v62, 16, v9
    v_and_b32 v63, 0xffff0000, v9
    v_lshlrev_b32 v64, 16, v10
    v_and_b32 v65, 0xffff0000, v10
    v_lshlrev_b32 v66, 16, v11
    v_and_b32 v67, 0xffff0000, v11
    v_mul_f32 v60, v60, v69
    v_mul_f32 v61, v61, v69
    v_mul_f32 v62, v62, v69
    v_mul_f32 v63, v63, v69
    v_mul_f32 v64, v64, v69
    v_mul_f32 v65, v65, v69
    v_mul_f32 v66, v66, v69
    v_mul_f32 v67, v67, v69
    v_cvt_pk_bf16_f32 v8, v60, v61
    v_cvt_pk_bf16_f32 v9, v62, v63
    v_cvt_pk_bf16_f32 v10, v64, v65
    v_cvt_pk_bf16_f32 v11, v66, v67
    v_readlane_b32 s66, v8, s62
    v_readlane_b32 s70, v8, s63
    v_readlane_b32 s67, v9, s62
    v_readlane_b32 s71, v9, s63
    v_readlane_b32 s68, v10, s62
    v_readlane_b32 s72, v10, s63
    v_readlane_b32 s69, v11, s62
    v_readlane_b32 s73, v11, s63
    v_mov_b32 v80, 0
    v_mov_b32 v81, 0
    v_mov_b32 v82, 0
    v_mov_b32 v83, 0
    v_mov_b32 v87, s35
    s_movk_i32 s62, 0x700
    s_min_u32 s3, s32, 27
    s_lshl_b32 s39, s3, 5
    s_add_u32 s38, s34, s39
    s_add_u32 s38, s38, 20480
    v_and_b32 v7, 1, v0
    v_lshrrev_b32 v13, 1, v0
    v_mul_u32_u24 v13, 896, v13
    v_lshl_add_u32 v13, v7, 4, v13
    v_add_u32 v13, s38, v13
    s_mul_i32 s38, s31, 224
    s_lshl_b32 s39, s3, 3
    s_add_u32 s38, s38, s39
    v_lshl_add_u32 v12, v7, 2, v6
    v_add_lshl_u32 v12, v12, s38, 1
    s_lshl_b32 s38, s38, 10
    s_add_u32 s38, s38, 4096
    v_lshlrev_b32 v14, 10, v6
    v_lshl_add_u32 v14, v5, 4, v14
    v_add_u32 v14, s38, v14
    s_lshr_b32 s38, s32, 1
    s_lshl_b32 s38, s38, 5
    s_and_b32 s39, s32, 1
    s_lshl_b32 s39, s39, 2
    s_add_u32 s38, s38, s39
    v_and_b32 v3, 3, v0
    v_lshl_add_u32 v15, v3, 3, v6
    v_add_lshl_u32 v15, v15, s38, 1
    v_mov_b32 v59, v12
    v_cmp_eq_u32 vcc, 1, v7
    v_mov_b32 v60, 0x0000ffff
    v_mov_b32 v61, 0xffff0000
    v_cndmask_b32 v60, v60, v61, vcc
    s_cmp_lt_u32 s32, 28
    s_cselect_b32 s38, -1, 0
    v_and_b32 v60, s38, v60
    v_bfe_u32 v61, v0, 1, 3
    v_cmp_eq_u32 vcc, 0, v61
    s_nop 1
    v_cndmask_b32 v120, 0, v60, vcc
    v_cmp_eq_u32 vcc, 1, v61
    s_nop 1
    v_cndmask_b32 v121, 0, v60, vcc
    v_cmp_eq_u32 vcc, 2, v61
    s_nop 1
    v_cndmask_b32 v122, 0, v60, vcc
    v_cmp_eq_u32 vcc, 3, v61
    s_nop 1
    v_cndmask_b32 v123, 0, v60, vcc
    v_cmp_eq_u32 vcc, 4, v61
    s_nop 1
    v_cndmask_b32 v124, 0, v60, vcc
    v_cmp_eq_u32 vcc, 5, v61
    s_nop 1
    v_cndmask_b32 v125, 0, v60, vcc
    v_cmp_eq_u32 vcc, 6, v61
    s_nop 1
    v_cndmask_b32 v126, 0, v60, vcc
    v_cmp_eq_u32 vcc, 7, v61
    s_nop 1
    v_cndmask_b32 v127, 0, v60, vcc
    s_lshl_b32 s39, s32, 6
    s_add_u32 s39, s39, s34
    s_add_u32 s39, s39, 212992
    v_lshrrev_b32 v8, 2, v5
    v_lshlrev_b32 v8, 1, v8
    v_and_b32 v9, 1, v6
    v_add_u32 v8, v8, v9
    v_lshrrev_b32 v9, 5, v0
    v_lshl_add_u32 v8, v9, 3, v8
    v_mul_u32_u24 v8, 2176, v8
    v_lshl_add_u32 v8, v3, 4, v8
    v_add_u32 v8, s39, v8
    v_add_u32 v9, 34816, v8
    s_mul_i32 s38, s32, 2176
    s_add_u32 s38, s38, s34
    s_add_u32 s38, s38, 212992
    v_add_u32 v10, s38, v2
    s_lshl_b32 s38, s32, 10
    s_add_u32 s38, s38, 2654208
    s_lshl_b32 s39, s31, 7
    s_add_u32 s39, s39, s38
    v_lshl_add_u32 v11, v6, 2, v3
    v_lshlrev_b32 v11, 3, v11
    v_bfe_u32 v12, v0, 2, 2
    v_lshl_add_u32 v12, v12, 7, v11
    v_add_u32 v12, s38, v12
    v_add_u32 v11, s39, v11
    v_mov_b32 v65, s35
    v_mov_b32 v55, 0
    v_add_u32 v19, 262144, v18
    s_movk_i32 s39, 7168
    v_mov_b32 v71, 0
    v_mov_b32 v75, 0
L_M_vi:
    s_sleep 1
    ds_read_b128 v[28:31], v1 offset:1312
    s_add_u32 s48, s48, 1
    s_cmp_gt_u32 s48, 400000
    s_cbranch_scc1 L_end
    s_waitcnt lgkmcnt(0)
    v_and_b32 v28, v28, v29
    v_and_b32 v30, v30, v31
    v_and_b32 v28, v28, v30
    v_cmp_eq_u32 vcc, 0, v28
    s_cbranch_vccnz L_M_vi
    s_mov_b32 s48, 0
    s_setprio 2
    s_mov_b64 exec, s[60:61]
    global_load_dwordx2 v[20:21], v4, s[16:17] nt
    global_load_dwordx2 v[22:23], v4, s[16:17] offset:3584 nt
    v_add_u32 v4, s39, v4
    global_load_dwordx2 v[24:25], v4, s[16:17] nt
    global_load_dwordx2 v[26:27], v4, s[16:17] offset:3584 nt
    v_add_u32 v4, s39, v4
    global_load_dwordx2 v[28:29], v4, s[16:17] nt
    global_load_dwordx2 v[30:31], v4, s[16:17] offset:3584 nt
    v_add_u32 v4, s39, v4
    global_load_dwordx2 v[32:33], v4, s[16:17] nt
    global_load_dwordx2 v[34:35], v4, s[16:17] offset:3584 nt
    v_add_u32 v4, s39, v4
    global_load_dwordx2 v[36:37], v4, s[16:17] nt
    global_load_dwordx2 v[38:39], v4, s[16:17] offset:3584 nt
    v_add_u32 v4, s39, v4
    global_load_dwordx2 v[40:41], v4, s[16:17] nt
    global_load_dwordx2 v[42:43], v4, s[16:17] offset:3584 nt
    v_add_u32 v4, s39, v4
    global_load_dwordx2 v[44:45], v4, s[16:17] nt
    global_load_dwordx2 v[46:47], v4, s[16:17] offset:3584 nt
    v_add_u32 v4, s39, v4
    global_load_dwordx2 v[48:49], v4, s[16:17] nt
    global_load_dwordx2 v[50:51], v4, s[16:17] offset:3584 nt
    global_load_dwordx4 v[128:131], v18, s[28:29] sc1
    s_mov_b64 exec, -1
    global_load_ushort v56, v59, s[18:19]
    global_load_ushort v57, v15, s[4:5]
    global_load_ushort v58, v15, s[22:23]
    global_load_dwordx4 v[88:91], v14, s[20:21] offset:-4096 nt
    global_load_dwordx4 v[92:95], v14, s[20:21] offset:0 nt
    global_load_dwordx4 v[96:99], v14, s[20:21] offset:-3840 nt
    global_load_dwordx4 v[100:103], v14, s[20:21] offset:256 nt
    global_load_dwordx4 v[104:107], v14, s[20:21] offset:-3584 nt
    global_load_dwordx4 v[108:111], v14, s[20:21] offset:512 nt
    global_load_dwordx4 v[112:115], v14, s[20:21] offset:-3328 nt
    global_load_dwordx4 v[116:119], v14, s[20:21] offset:768 nt
    global_load_dwordx4 v[68:71], v10, s[28:29] offset:0 sc1
    global_load_dwordx4 v[72:75], v10, s[28:29] offset:1024 sc1
    s_waitcnt vmcnt(28)
    v_perm_b32 v60, v22, v20, s40
    v_perm_b32 v61, v22, v20, s41
    v_perm_b32 v62, v23, v21, s40
    v_perm_b32 v63, v23, v21, s41
    v_dot2c_f32_bf16 v80, s66, v60
    v_dot2c_f32_bf16 v81, s66, v61
    v_dot2c_f32_bf16 v82, s66, v62
    v_dot2c_f32_bf16 v83, s66, v63
    s_waitcnt vmcnt(26)
    v_perm_b32 v60, v26, v24, s40
    v_perm_b32 v61, v26, v24, s41
    v_perm_b32 v62, v27, v25, s40
    v_perm_b32 v63, v27, v25, s41
    v_dot2c_f32_bf16 v80, s67, v60
    v_dot2c_f32_bf16 v81, s67, v61
    v_dot2c_f32_bf16 v82, s67, v62
    v_dot2c_f32_bf16 v83, s67, v63
    s_waitcnt vmcnt(24)
    v_perm_b32 v60, v30, v28, s40
    v_perm_b32 v61, v30, v28, s41
    v_perm_b32 v62, v31, v29, s40
    v_perm_b32 v63, v31, v29, s41
    v_dot2c_f32_bf16 v80, s68, v60
    v_dot2c_f32_bf16 v81, s68, v61
    v_dot2c_f32_bf16 v82, s68, v62
    v_dot2c_f32_bf16 v83, s68, v63
    s_waitcnt vmcnt(22)
    v_perm_b32 v60, v34, v32, s40
    v_perm_b32 v61, v34, v32, s41
    v_perm_b32 v62, v35, v33, s40
    v_perm_b32 v63, v35, v33, s41
    v_dot2c_f32_bf16 v80, s69, v60
    v_dot2c_f32_bf16 v81, s69, v61
    v_dot2c_f32_bf16 v82, s69, v62
    v_dot2c_f32_bf16 v83, s69, v63
    s_waitcnt vmcnt(20)
    v_perm_b32 v60, v38, v36, s40
    v_perm_b32 v61, v38, v36, s41
    v_perm_b32 v62, v39, v37, s40
    v_perm_b32 v63, v39, v37, s41
    v_dot2c_f32_bf16 v80, s70, v60
    v_dot2c_f32_bf16 v81, s70, v61
    v_dot2c_f32_bf16 v82, s70, v62
    v_dot2c_f32_bf16 v83, s70, v63
    s_waitcnt vmcnt(18)
    v_perm_b32 v60, v42, v40, s40
    v_perm_b32 v61, v42, v40, s41
    v_perm_b32 v62, v43, v41, s40
    v_perm_b32 v63, v43, v41, s41
    v_dot2c_f32_bf16 v80, s71, v60
    v_dot2c_f32_bf16 v81, s71, v61
    v_dot2c_f32_bf16 v82, s71, v62
    v_dot2c_f32_bf16 v83, s71, v63
    s_waitcnt vmcnt(16)
    v_perm_b32 v60, v46, v44, s40
    v_perm_b32 v61, v46, v44, s41
    v_perm_b32 v62, v47, v45, s40
    v_perm_b32 v63, v47, v45, s41
    v_dot2c_f32_bf16 v80, s72, v60
    v_dot2c_f32_bf16 v81, s72, v61
    v_dot2c_f32_bf16 v82, s72, v62
    v_dot2c_f32_bf16 v83, s72, v63
    s_waitcnt vmcnt(14)
    v_perm_b32 v60, v50, v48, s40
    v_perm_b32 v61, v50, v48, s41
    v_perm_b32 v62, v51, v49, s40
    v_perm_b32 v63, v51, v49, s41
    v_dot2c_f32_bf16 v80, s73, v60
    v_dot2c_f32_bf16 v81, s73, v61
    v_dot2c_f32_bf16 v82, s73, v62
    v_dot2c_f32_bf16 v83, s73, v63
    s_nop 2
    v_perm_b32 v84, v80, v83, s42
    v_perm_b32 v85, v81, v83, s43
    v_perm_b32 v86, v82, v83, s44
    v_bfi_b32 v84, s62, v17, v84
    s_mov_b64 exec, s[60:61]
    global_store_dwordx4 v18, v[84:87], s[28:29]
    global_store_dwordx4 v19, v[84:87], s[28:29] sc1
    s_mov_b64 exec, -1
    s_mov_b32 s60, 0x000f000f
    s_mov_b32 s61, 0x000f000f
    v_mov_b32 v39, s35
    v_mov_b32 v43, s35
L_M_fz:
    ds_read_b32 v28, v1 offset:1480
    s_add_u32 s48, s48, 1
    s_cmp_gt_u32 s48, 400000
    s_cbranch_scc1 L_end
    s_waitcnt lgkmcnt(0)
    v_cmp_eq_u32 vcc, 0, v28
    s_cbranch_vccnz L_M_fz
    s_mov_b32 s48, 0
    s_mov_b64 s[50:51], -1
L_MH_l:
    s_cmp_eq_u32 s48, 64
    s_cbranch_scc1 L_MH_sw
    s_wqm_b64 exec, s[50:51]
    global_load_dwordx4 v[52:55], v13, s[28:29] sc1
    s_mov_b64 exec, -1
    s_add_u32 s48, s48, 1
    s_cmp_gt_u32 s48, 400000
    s_cbranch_scc1 L_end
    s_waitcnt vmcnt(56)
    s_sleep 1
    v_cmp_ne_u32 s[50:51], s35, v55
    s_cmp_lg_u64 s[50:51], 0
    s_cbranch_scc0 L_MH_x
    s_sleep 1
L_MH_c:
    v_cmp_ne_u32 s[50:51], s35, v55
    s_cmp_lg_u64 s[50:51], 0
    s_cbranch_scc1 L_MH_l
L_MH_x:
    v_bfe_u32 v60, v52, 8, 3
    v_cmp_ne_u32 s[52:53], s33, v60
    v_mov_b32 v132, v52
    v_mov_b32 v133, v53
    v_mov_b32 v134, v54
    v_perm_b32 v135, v53, v52, s45
    v_perm_b32 v135, v54, v135, s46
    v_lshlrev_b32 v56, 16, v56
    v_permlane32_swap_b32 v132, v134
    v_permlane32_swap_b32 v133, v135
    v_add_f32 v132, v132, v134
    v_add_f32 v133, v133, v135
    s_nop 1
    v_permlane16_swap_b32 v132, v133
    v_add_f32 v132, v132, v133
    s_nop 1
    v_add_f32_dpp v132, v132, v132 row_ror:8 row_mask:0xf bank_mask:0xf
    s_nop 1
    v_add_f32_dpp v132, v132, v132 row_ror:4 row_mask:0xf bank_mask:0xf
    s_nop 1
    v_add_f32_dpp v132, v132, v132 row_ror:2 row_mask:0xf bank_mask:0xf
    v_cvt_pk_bf16_f32 v132, v132, v132
    v_and_b32 v132, 0xffff0000, v132
    v_add_f32 v132, v132, v56
    v_cvt_pk_bf16_f32 v132, v132, v132
    v_and_b32 v132, 0xffff0000, v132
    s_mov_b32 s38, 0x3d372713
    s_mov_b32 s39, 0xc0135761
    v_mul_f32 v133, v132, v132
    v_fma_f32 v133, v133, s38, 1.0
    v_mul_f32 v133, v133, v132
    v_mul_f32 v133, s39, v133
    v_exp_f32 v133, v133
    s_nop 0
    v_add_f32 v133, 1.0, v133
    v_rcp_f32 v133, v133
    s_nop 0
    v_mul_f32 v132, v132, v133
    v_cvt_pk_bf16_f32 v132, v132, v132
    s_nop 1
    v_and_b32_dpp v20, v132, v120 quad_perm:[0,0,0,0] row_mask:0xf bank_mask:0xf
    v_and_b32_dpp v21, v132, v121 quad_perm:[0,0,0,0] row_mask:0xf bank_mask:0xf
    v_and_b32_dpp v22, v132, v122 quad_perm:[0,0,0,0] row_mask:0xf bank_mask:0xf
    v_and_b32_dpp v23, v132, v123 quad_perm:[0,0,0,0] row_mask:0xf bank_mask:0xf
    v_and_b32_dpp v24, v132, v120 quad_perm:[1,1,1,1] row_mask:0xf bank_mask:0xf
    v_and_b32_dpp v25, v132, v121 quad_perm:[1,1,1,1] row_mask:0xf bank_mask:0xf
    v_and_b32_dpp v26, v132, v122 quad_perm:[1,1,1,1] row_mask:0xf bank_mask:0xf
    v_and_b32_dpp v27, v132, v123 quad_perm:[1,1,1,1] row_mask:0xf bank_mask:0xf
    v_and_b32_dpp v28, v132, v124 quad_perm:[0,0,0,0] row_mask:0xf bank_mask:0xf
    v_and_b32_dpp v29, v132, v125 quad_perm:[0,0,0,0] row_mask:0xf bank_mask:0xf
    v_and_b32_dpp v30, v132, v126 quad_perm:[0,0,0,0] row_mask:0xf bank_mask:0xf
    v_and_b32_dpp v31, v132, v127 quad_perm:[0,0,0,0] row_mask:0xf bank_mask:0xf
    v_and_b32_dpp v32, v132, v124 quad_perm:[1,1,1,1] row_mask:0xf bank_mask:0xf
    v_and_b32_dpp v33, v132, v125 quad_perm:[1,1,1,1] row_mask:0xf bank_mask:0xf
    v_and_b32_dpp v34, v132, v126 quad_perm:[1,1,1,1] row_mask:0xf bank_mask:0xf
    v_and_b32_dpp v35, v132, v127 quad_perm:[1,1,1,1] row_mask:0xf bank_mask:0xf
    v_mfma_f32_16x16x32_bf16 v[76:79], v[20:23], v[88:91], 0
    v_mfma_f32_16x16x32_bf16 v[80:83], v[20:23], v[104:107], 0
    v_mfma_f32_16x16x32_bf16 v[76:79], v[24:27], v[92:95], v[76:79]
    v_mfma_f32_16x16x32_bf16 v[80:83], v[24:27], v[108:111], v[80:83]
    v_mfma_f32_16x16x32_bf16 v[76:79], v[28:31], v[96:99], v[76:79]
    v_mfma_f32_16x16x32_bf16 v[80:83], v[28:31], v[112:115], v[80:83]
    v_mfma_f32_16x16x32_bf16 v[76:79], v[32:35], v[100:103], v[76:79]
    v_mfma_f32_16x16x32_bf16 v[80:83], v[32:35], v[116:119], v[80:83]
    s_nop 6
    v_perm_b32 v36, v76, v79, s42
    v_perm_b32 v37, v77, v79, s43
    v_perm_b32 v38, v78, v79, s44
    v_perm_b32 v40, v80, v83, s42
    v_perm_b32 v41, v81, v83, s43
    v_perm_b32 v42, v82, v83, s44
    s_cmp_lg_u64 s[52:53], 0
    s_cbranch_scc1 L_stm_slow
    global_store_dwordx4 v8, v[36:39], s[28:29]
    global_store_dwordx4 v9, v[40:43], s[28:29]
L_stm_done:
    s_mov_b64 s[50:51], -1
L_MI_l:
    s_wqm_b64 exec, s[50:51]
    global_load_dwordx4 v[68:71], v10, s[28:29] offset:0 sc1
    global_load_dwordx4 v[72:75], v10, s[28:29] offset:1024 sc1
    s_mov_b64 exec, -1
    s_add_u32 s48, s48, 1
    s_cmp_gt_u32 s48, 400000
    s_cbranch_scc1 L_end
    s_waitcnt vmcnt(56)
    s_sleep 1
L_MI_c:
    v_cmp_ne_u32 s[50:51], s35, v71
    v_cmp_ne_u32 s[52:53], s35, v75
    s_or_b64 s[50:51], s[50:51], s[52:53]
    s_cbranch_scc1 L_MI_l
L_MI_x:
    v_perm_b32 v63, v69, v68, s45
    v_perm_b32 v63, v70, v63, s46
    v_perm_b32 v66, v73, v72, s45
    v_perm_b32 v66, v74, v66, s46
    v_add_f32 v60, v68, v72
    v_add_f32 v61, v69, v73
    v_add_f32 v62, v70, v74
    v_add_f32 v63, v63, v66
    s_nop 0
    v_permlane32_swap_b32 v60, v62
    v_permlane32_swap_b32 v61, v63
    v_add_f32 v60, v60, v62
    v_add_f32 v61, v61, v63
    s_nop 1
    v_permlane16_swap_b32 v60, v61
    v_add_f32 v60, v60, v61
    s_nop 1
    v_add_f32_dpp v60, v60, v60 row_ror:8 row_mask:0xf bank_mask:0xf
    s_nop 1
    v_add_f32_dpp v64, v60, v60 row_ror:4 row_mask:0xf bank_mask:0xf
    s_mov_b64 exec, s[60:61]
    global_store_dwordx2 v11, v[64:65], s[28:29] sc1
    s_mov_b64 exec, -1
    s_and_b32 s38, s32, 7
    s_cmp_lg_u32 s38, s31
    s_cbranch_scc1 L_wb
    v_add_u32 v13, 4294934528, v12
    v_lshlrev_b32 v57, 16, v57
    v_lshlrev_b32 v58, 16, v58
    v_mov_b32 v21, 0
    v_mov_b32 v23, 0
    v_mov_b32 v25, 0
    v_mov_b32 v27, 0
    s_mov_b32 s39, 0xbfb8aa3b
L_M_fe:
    s_sleep 1
    ds_read_b32 v28, v1 offset:1476
    s_add_u32 s48, s48, 1
    s_cmp_gt_u32 s48, 400000
    s_cbranch_scc1 L_end
    s_waitcnt lgkmcnt(0)
    v_cmp_eq_u32 vcc, 0, v28
    s_cbranch_vccnz L_M_fe
    s_setprio 3
    s_mov_b64 s[50:51], -1
L_HM_l:
    s_wqm_b64 exec, s[50:51]
    global_load_dwordx2 v[20:21], v12, s[28:29] offset:0 sc1
    global_load_dwordx2 v[22:23], v12, s[28:29] offset:512 sc1
    global_load_dwordx2 v[24:25], v13, s[28:29] offset:0 sc1
    global_load_dwordx2 v[26:27], v13, s[28:29] offset:512 sc1
    s_mov_b64 exec, -1
    s_add_u32 s48, s48, 1
    s_cmp_gt_u32 s48, 400000
    s_cbranch_scc1 L_end
    s_sleep 1
    s_waitcnt vmcnt(32)
    v_cmp_ne_u32 s[50:51], s35, v25
    v_cmp_ne_u32 s[52:53], s35, v27
    v_cmp_ne_u32 s[54:55], s35, v21
    v_cmp_ne_u32 s[56:57], s35, v23
    s_or_b64 s[50:51], s[50:51], s[52:53]
    s_or_b64 s[50:51], s[50:51], s[54:55]
    s_or_b64 s[50:51], s[50:51], s[56:57]
    s_or_b64 s[54:55], s[54:55], s[56:57]
    s_cbranch_scc1 L_HM_l
    global_load_dwordx2 v[24:25], v13, s[28:29] offset:0 sc1
    global_load_dwordx2 v[26:27], v13, s[28:29] offset:512 sc1
    v_add_f32 v30, v20, v22
    s_nop 1
    v_add_f32_dpp v30, v30, v30 row_ror:8 row_mask:0xf bank_mask:0xf
    s_nop 1
    v_add_f32_dpp v30, v30, v30 row_ror:4 row_mask:0xf bank_mask:0xf
    v_cvt_pk_bf16_f32 v30, v30, v30
    v_and_b32 v30, 0xffff0000, v30
    v_add_f32 v30, v30, v58
    v_cvt_pk_bf16_f32 v30, v30, v30
    v_and_b32 v30, 0xffff0000, v30
    v_mul_f32 v31, s39, v30
    v_exp_f32 v31, v31
    s_nop 0
    v_add_f32 v31, 1.0, v31
    v_rcp_f32 v31, v31
    s_nop 0
    v_mul_f32 v30, v30, v31
    v_cvt_pk_bf16_f32 v30, v30, v30
    v_and_b32 v30, 0xffff0000, v30
    s_branch L_HS_c
L_HS_l:
    s_wqm_b64 exec, s[50:51]
    global_load_dwordx2 v[24:25], v13, s[28:29] offset:0 sc1
    global_load_dwordx2 v[26:27], v13, s[28:29] offset:512 sc1
    s_mov_b64 exec, -1
    s_add_u32 s48, s48, 1
    s_cmp_gt_u32 s48, 400000
    s_cbranch_scc1 L_end
    s_waitcnt vmcnt(56)
    s_sleep 1
L_HS_c:
    v_cmp_ne_u32 s[50:51], s35, v25
    v_cmp_ne_u32 s[52:53], s35, v27
    s_or_b64 s[50:51], s[50:51], s[52:53]
    s_cbranch_scc1 L_HS_l
L_HS_x:
    v_add_f32 v32, v24, v26
    s_nop 1
    v_add_f32_dpp v32, v32, v32 row_ror:8 row_mask:0xf bank_mask:0xf
    s_nop 1
    v_add_f32_dpp v32, v32, v32 row_ror:4 row_mask:0xf bank_mask:0xf
    v_cvt_pk_bf16_f32 v32, v32, v32
    v_and_b32 v32, 0xffff0000, v32
    v_mul_f32 v32, v32, v30
    v_cvt_pk_bf16_f32 v32, v32, v32
    v_and_b32 v32, 0xffff0000, v32
    v_add_f32 v32, v32, v57
    v_cvt_pk_bf16_f32 v32, v32, v32
    s_mov_b64 exec, s[60:61]
    global_store_short v15, v32, s[24:25] sc1
    s_cmp_lg_u32 s2, 0
    s_cbranch_scc1 L_fin
    s_mov_b64 exec, 1
    v_mov_b32 v4, s35
    global_store_dword v1, v4, s[28:29] sc1
    s_branch L_fin
L_A2:
    s_waitcnt vmcnt(10)
    v_cmp_ne_u32 s[50:51], s35, v163
    v_cmp_ne_u32 s[52:53], s35, v167
    s_or_b64 s[50:51], s[50:51], s[52:53]
    s_cbranch_scc0 L_P_ok
    s_waitcnt vmcnt(5)
    v_cmp_ne_u32 s[50:51], s35, v163
    v_cmp_ne_u32 s[52:53], s35, v167
    s_or_b64 s[50:51], s[50:51], s[52:53]
    s_cbranch_scc0 L_P_ok
    s_waitcnt vmcnt(0)
    s_branch L_P_chk
L_P_retry:
    s_add_u32 s48, s48, 1
    s_cmp_eq_u32 s48, 16
    s_cselect_b32 s38, 8192, 0
    v_add_u32 v12, s38, v12
    s_wqm_b64 exec, s[50:51]
    global_load_dwordx4 v[160:163], v12, s[28:29] sc1
    global_load_dwordx4 v[164:167], v12, s[28:29] offset:256 sc1
    s_mov_b64 exec, -1
    s_cmp_gt_u32 s48, 400000
    s_cbranch_scc1 L_end
    s_waitcnt vmcnt(0)
L_P_chk:
    v_cmp_ne_u32 s[50:51], s35, v163
    v_cmp_ne_u32 s[52:53], s35, v167
    s_or_b64 s[50:51], s[50:51], s[52:53]
    s_cbranch_scc1 L_P_retry
L_P_ok:
    v_bfe_u32 v144, v160, 8, 3
    v_bfe_u32 v145, v164, 8, 3
    v_cmp_ne_u32 s[50:51], s33, v144
    v_cmp_ne_u32 s[52:53], s33, v145
    v_perm_b32 v99, v161, v160, s45
    v_perm_b32 v99, v162, v99, s46
    v_perm_b32 v100, v165, v164, s45
    v_perm_b32 v100, v166, v100, s46
    v_add_f32 v96, v160, v164
    v_add_f32 v97, v161, v165
    v_add_f32 v98, v162, v166
    v_add_f32 v99, v99, v100
    s_or_b64 s[50:51], s[50:51], s[52:53]
    s_cselect_b32 s49, 3, 1
    v_mov_b32 v144, s49
    v_permlane32_swap_b32 v96, v98
    v_permlane32_swap_b32 v97, v99
    v_add_f32 v96, v96, v98
    v_add_f32 v97, v97, v99
    v_cvt_pk_bf16_f32 v96, v96, v97
    ds_write_b32 v17, v96
    ds_write_b32 v16, v144 offset:1280
L_q_spin:
    ds_read_b128 v[96:99], v1 offset:1280
    ds_read_b32 v100, v1 offset:1296
    ds_read_b128 v[120:123], v18 offset:0
    ds_read_b128 v[124:127], v18 offset:64
    ds_read_b128 v[128:131], v18 offset:128
    ds_read_b128 v[132:135], v18 offset:192
    s_add_u32 s48, s48, 1
    s_cmp_gt_u32 s48, 400000
    s_cbranch_scc1 L_end
    s_waitcnt lgkmcnt(4)
    v_and_b32 v144, v96, v97
    v_and_b32 v145, v98, v99
    v_and_b32 v144, v144, v100
    v_and_b32 v144, v144, v145
    v_and_b32 v144, 1, v144
    v_cmp_eq_u32 vcc, 0, v144
    s_cbranch_vccnz L_q_spin
    s_waitcnt lgkmcnt(3)
    v_mfma_f32_16x16x32_bf16 v[136:139], v[32:35], v[120:123], 0
    v_mfma_f32_16x16x32_bf16 v[140:143], v[48:51], v[120:123], 0
    v_or3_b32 v146, v96, v97, v98
    v_or_b32 v146, v146, v99
    s_waitcnt lgkmcnt(2)
    v_mfma_f32_16x16x32_bf16 v[136:139], v[36:39], v[124:127], v[136:139]
    v_mfma_f32_16x16x32_bf16 v[140:143], v[52:55], v[124:127], v[140:143]
    v_readfirstlane_b32 s49, v146
    s_waitcnt lgkmcnt(1)
    v_mfma_f32_16x16x32_bf16 v[136:139], v[40:43], v[128:131], v[136:139]
    v_mfma_f32_16x16x32_bf16 v[140:143], v[56:59], v[128:131], v[140:143]
    s_waitcnt lgkmcnt(0)
    v_mfma_f32_16x16x32_bf16 v[136:139], v[44:47], v[132:135], v[136:139]
    v_mfma_f32_16x16x32_bf16 v[140:143], v[60:63], v[132:135], v[140:143]
    s_and_b32 s49, s49, 2
    s_nop 5
    v_max3_f32 v144, v136, v137, v138
    v_max3_f32 v145, v139, v140, v141
    v_max3_f32 v144, v144, v142, v143
    v_max_f32 v144, v144, v145
    v_mov_b32 v145, v144
    s_nop 1
    v_permlane32_swap_b32 v144, v145
    v_max_f32 v144, v144, v145
    v_mov_b32 v145, v144
    s_nop 1
    v_permlane16_swap_b32 v144, v145
    v_max_f32 v144, v144, v145
    v_mul_f32 v144, v144, v100
    v_fma_f32 v136, v136, v100, -v144
    v_fma_f32 v137, v137, v100, -v144
    v_fma_f32 v138, v138, v100, -v144
    v_fma_f32 v139, v139, v100, -v144
    v_fma_f32 v140, v140, v100, -v144
    v_fma_f32 v141, v141, v100, -v144
    v_fma_f32 v142, v142, v100, -v144
    v_fma_f32 v143, v143, v100, -v144
    v_exp_f32 v136, v136
    v_exp_f32 v137, v137
    v_exp_f32 v138, v138
    v_exp_f32 v139, v139
    v_exp_f32 v140, v140
    v_exp_f32 v141, v141
    v_exp_f32 v142, v142
    v_exp_f32 v143, v143
    v_add_f32 v145, v136, v137
    v_add_f32 v146, v138, v139
    v_add_f32 v147, v140, v141
    v_add_f32 v145, v145, v146
    v_add_f32 v146, v142, v143
    v_add_f32 v145, v145, v147
    v_add_f32 v145, v145, v146
    v_mov_b32 v146, v145
    s_nop 1
    v_permlane32_swap_b32 v145, v146
    v_add_f32 v145, v145, v146
    v_mov_b32 v146, v145
    s_nop 1
    v_permlane16_swap_b32 v145, v146
    v_add_f32 v145, v145, v146
    ds_write_b64 v19, v[144:145] offset:1344
    v_cvt_pk_bf16_f32 v96, v136, v137
    v_cvt_pk_bf16_f32 v97, v138, v139
    v_cvt_pk_bf16_f32 v98, v140, v141
    v_cvt_pk_bf16_f32 v99, v142, v143
    v_cndmask_b32 v120, 0, v96, s[66:67]
    v_cndmask_b32 v121, 0, v97, s[66:67]
    v_cndmask_b32 v122, 0, v98, s[66:67]
    v_cndmask_b32 v123, 0, v99, s[66:67]
    v_cndmask_b32 v124, 0, v96, s[68:69]
    v_cndmask_b32 v125, 0, v97, s[68:69]
    v_cndmask_b32 v126, 0, v98, s[68:69]
    v_cndmask_b32 v127, 0, v99, s[68:69]
    v_cndmask_b32 v128, 0, v96, s[70:71]
    v_cndmask_b32 v129, 0, v97, s[70:71]
    v_cndmask_b32 v130, 0, v98, s[70:71]
    v_cndmask_b32 v131, 0, v99, s[70:71]
    v_cndmask_b32 v132, 0, v96, s[72:73]
    v_cndmask_b32 v133, 0, v97, s[72:73]
    v_cndmask_b32 v134, 0, v98, s[72:73]
    v_cndmask_b32 v135, 0, v99, s[72:73]
    v_mov_b32 v103, s35
    ds_read_b128 v[144:147], v24 offset:1344
    ds_read_b128 v[148:151], v24 offset:1360
    s_waitcnt vmcnt(12)
    v_perm_b32 v32, v68, v64, s40
    v_perm_b32 v36, v68, v64, s41
    v_perm_b32 v40, v69, v65, s40
    v_perm_b32 v44, v69, v65, s41
    v_perm_b32 v48, v70, v66, s40
    v_perm_b32 v52, v70, v66, s41
    v_perm_b32 v56, v71, v67, s40
    v_perm_b32 v60, v71, v67, s41
    s_branch L_ml_chk
L_ml_spin:
    ds_read_b128 v[144:147], v24 offset:1344
    ds_read_b128 v[148:151], v24 offset:1360
    s_add_u32 s48, s48, 1
    s_cmp_gt_u32 s48, 400000
    s_cbranch_scc1 L_end
    s_waitcnt lgkmcnt(0)
L_ml_chk:
    s_waitcnt lgkmcnt(0)
    v_min_u32 v152, v145, v147
    v_min3_u32 v152, v152, v149, v151
    v_max3_f32 v100, v144, v146, v148
    v_cmp_eq_u32 vcc, 0, v152
    v_max_f32 v100, v100, v150
    s_cbranch_vccnz L_ml_spin
    v_sub_f32 v156, v144, v100
    v_sub_f32 v157, v146, v100
    v_sub_f32 v158, v148, v100
    v_sub_f32 v159, v150, v100
    v_exp_f32 v156, v156
    v_exp_f32 v157, v157
    v_exp_f32 v158, v158
    v_exp_f32 v159, v159
    v_mul_f32 v101, v156, v145
    v_fmac_f32 v101, v157, v147
    v_fmac_f32 v101, v158, v149
    v_fmac_f32 v101, v159, v151
    s_cmp_lg_u32 s49, 0
    s_mov_b64 exec, 1
    s_cbranch_scc1 L_stml_slow
    global_store_dwordx4 v13, v[100:103], s[28:29]
L_stml_done:
    s_mov_b64 exec, -1
    global_load_dwordx4 v[104:107], v9, s[12:13] offset:-4096 nt
    global_load_dwordx4 v[108:111], v9, s[12:13] offset:0 nt
    global_load_dwordx4 v[112:115], v14, s[12:13] offset:-4096 nt
    global_load_dwordx4 v[116:119], v14, s[12:13] offset:0 nt
    s_waitcnt vmcnt(13)
    v_perm_b32 v33, v76, v72, s40
    v_perm_b32 v37, v76, v72, s41
    v_perm_b32 v41, v77, v73, s40
    v_perm_b32 v45, v77, v73, s41
    v_perm_b32 v49, v78, v74, s40
    v_perm_b32 v53, v78, v74, s41
    v_perm_b32 v57, v79, v75, s40
    v_perm_b32 v61, v79, v75, s41
    s_waitcnt vmcnt(9)
    v_perm_b32 v34, v84, v80, s40
    v_perm_b32 v38, v84, v80, s41
    v_perm_b32 v42, v85, v81, s40
    v_perm_b32 v46, v85, v81, s41
    v_perm_b32 v50, v86, v82, s40
    v_perm_b32 v54, v86, v82, s41
    v_perm_b32 v58, v87, v83, s40
    v_perm_b32 v62, v87, v83, s41
    v_mov_b32 v99, s35
    s_waitcnt vmcnt(7)
    v_perm_b32 v35, v92, v88, s40
    v_perm_b32 v39, v92, v88, s41
    v_perm_b32 v43, v93, v89, s40
    v_mfma_f32_16x16x32_bf16 v[136:139], v[120:123], v[32:35], 0
    v_perm_b32 v47, v93, v89, s41
    v_mfma_f32_16x16x32_bf16 v[136:139], v[124:127], v[36:39], v[136:139]
    v_perm_b32 v51, v94, v90, s40
    v_mfma_f32_16x16x32_bf16 v[136:139], v[128:131], v[40:43], v[136:139]
    v_perm_b32 v55, v94, v90, s41
    v_mfma_f32_16x16x32_bf16 v[136:139], v[132:135], v[44:47], v[136:139]
    v_perm_b32 v59, v95, v91, s40
    v_mfma_f32_16x16x32_bf16 v[140:143], v[120:123], v[48:51], 0
    v_perm_b32 v63, v95, v91, s41
    v_mfma_f32_16x16x32_bf16 v[140:143], v[124:127], v[52:55], v[140:143]
    v_mfma_f32_16x16x32_bf16 v[140:143], v[128:131], v[56:59], v[140:143]
    v_mfma_f32_16x16x32_bf16 v[140:143], v[132:135], v[60:63], v[140:143]
    s_nop 1
    ds_write_b128 v21, v[136:139]
    s_nop 4
    ds_write_b128 v21, v[140:143] offset:1152
    ds_write_b32 v16, v25 offset:1328
L_o_spin:
    ds_read_b128 v[152:155], v1 offset:1328
    ds_read_b128 v[64:67], v22 offset:0
    ds_read_b128 v[68:71], v22 offset:2304
    ds_read_b128 v[72:75], v22 offset:4608
    ds_read_b128 v[76:79], v22 offset:6912
    s_add_u32 s48, s48, 1
    s_cmp_gt_u32 s48, 400000
    s_cbranch_scc1 L_end
    s_waitcnt lgkmcnt(4)
    v_and_b32 v152, v152, v153
    v_and_b32 v154, v154, v155
    v_and_b32 v152, v152, v154
    v_cmp_eq_u32 vcc, 0, v152
    s_cbranch_vccnz L_o_spin
    s_waitcnt lgkmcnt(3)
    v_mul_f32 v64, v64, v156
    v_mul_f32 v65, v65, v156
    v_mul_f32 v66, v66, v156
    v_mul_f32 v67, v67, v156
    s_waitcnt lgkmcnt(2)
    v_fmac_f32 v64, v68, v157
    v_fmac_f32 v65, v69, v157
    v_fmac_f32 v66, v70, v157
    v_fmac_f32 v67, v71, v157
    s_waitcnt lgkmcnt(1)
    v_fmac_f32 v64, v72, v158
    v_fmac_f32 v65, v73, v158
    v_fmac_f32 v66, v74, v158
    v_fmac_f32 v67, v75, v158
    s_waitcnt lgkmcnt(0)
    v_fmac_f32 v64, v76, v159
    v_fmac_f32 v65, v77, v159
    v_fmac_f32 v66, v78, v159
    v_fmac_f32 v67, v79, v159
    s_cmp_lg_u32 s49, 0
    s_mov_b32 exec_hi, 0
    v_perm_b32 v96, v64, v67, s42
    v_perm_b32 v97, v65, v67, s43
    v_perm_b32 v98, v66, v67, s44
    s_cbranch_scc1 L_st2_slow
    global_store_dwordx4 v10, v[96:99], s[28:29]
L_st2_done:
    s_mov_b64 exec, -1
    s_waitcnt vmcnt(4)
    ds_write_b32 v1, v25 offset:1480
    v_lshlrev_b32 v15, 4, v6
    s_waitcnt vmcnt(1)
L_t_spin:
    ds_read_b32 v148, v1 offset:1472
    ds_read_b128 v[144:147], v15 offset:1536
    s_add_u32 s48, s48, 1
    s_cmp_gt_u32 s48, 400000
    s_cbranch_scc1 L_end
    s_waitcnt lgkmcnt(0)
    v_cmp_eq_u32 vcc, 0, v148
    v_and_b32 v120, v144, v28
    v_and_b32 v121, v144, v29
    v_and_b32 v122, v144, v30
    v_and_b32 v123, v144, v31
    s_cbranch_vccnz L_t_spin
    v_and_b32 v124, v145, v28
    v_and_b32 v125, v145, v29
    v_and_b32 v126, v145, v30
    v_and_b32 v127, v145, v31
    v_mfma_f32_16x16x32_bf16 v[136:139], v[120:123], v[104:107], 0
    v_and_b32 v128, v146, v28
    v_and_b32 v129, v146, v29
    v_and_b32 v130, v146, v30
    v_and_b32 v131, v146, v31
    v_mfma_f32_16x16x32_bf16 v[136:139], v[124:127], v[108:111], v[136:139]
    v_and_b32 v132, v147, v28
    v_and_b32 v133, v147, v29
    v_and_b32 v134, v147, v30
    v_and_b32 v135, v147, v31
    v_mfma_f32_16x16x32_bf16 v[136:139], v[128:131], v[112:115], v[136:139]
    s_nop 0
    v_mfma_f32_16x16x32_bf16 v[136:139], v[132:135], v[116:119], v[136:139]
    s_cmp_lg_u32 s49, 0
    s_mov_b32 exec_hi, 0
    s_nop 5
    v_perm_b32 v96, v136, v139, s42
    v_perm_b32 v97, v137, v139, s43
    v_perm_b32 v98, v138, v139, s44
    s_cbranch_scc1 L_st3_slow
    global_store_dwordx4 v11, v[96:99], s[28:29]
L_st3_done:
L_fin:
    s_endpgm
L_MH_sw:
    s_waitcnt vmcnt(0)
    v_add_u32 v13, 262144, v13
    s_add_u32 s48, s48, 1
    s_branch L_MH_c
L_stm_slow:
    global_store_dwordx4 v8, v[36:39], s[28:29] sc1
    global_store_dwordx4 v9, v[40:43], s[28:29] sc1
    s_branch L_stm_done
L_wb:
    s_add_u32 s38, s31, 1
    s_and_b32 s38, s38, 7
    s_cmp_lg_u32 s38, s32
    s_cbranch_scc1 L_fin
L_wb2:
    s_sleep 1
    ds_read_b32 v28, v1 offset:1476
    s_add_u32 s48, s48, 1
    s_cmp_gt_u32 s48, 400000
    s_cbranch_scc1 L_end
    s_waitcnt lgkmcnt(0)
    v_cmp_eq_u32 vcc, 0, v28
    s_cbranch_vccnz L_wb2
    buffer_wbl2 sc1
    s_waitcnt vmcnt(0)
    s_branch L_fin
L_stml_slow:
    global_store_dwordx4 v13, v[100:103], s[28:29] sc1
    s_branch L_stml_done
L_st2_slow:
    global_store_dwordx4 v10, v[96:99], s[28:29] sc1
    s_branch L_st2_done
L_st3_slow:
    global_store_dwordx4 v11, v[96:99], s[28:29] sc1
    s_branch L_st3_done
L_end:
    s_endpgm
.section .rodata,"a"
.p2align 6
.amdhsa_kernel recurrent_scan__sliding_block_cached__mixer_channel_mlp__decode_kernel
  .amdhsa_next_free_vgpr 168
  .amdhsa_next_free_sgpr 102
  .amdhsa_accum_offset 168
  .amdhsa_group_segment_fixed_size 0
  .amdhsa_kernarg_size 104
  .amdhsa_user_sgpr_count 2
  .amdhsa_user_sgpr_kernarg_segment_ptr 1
  .amdhsa_system_sgpr_workgroup_id_x 1
.end_amdhsa_kernel
```
